```python
import torch

def _softmax(x, axis=-1):
    return torch.softmax(x, dim=axis)
def _gelu(x):
    return torch.nn.functional.gelu(x, approximate="tanh")
def _silu(x):
    return torch.nn.functional.silu(x)
def _sigmoid(x):
    return torch.sigmoid(x)
def _layernorm(x, axis=-1, eps=1e-5):
    m = x.mean(dim=axis, keepdim=True)
    v = x.var(dim=axis, keepdim=True, unbiased=False)
    return (x - m) / torch.sqrt(v + eps)
def _scatter_add(tgt, idx, src, axis=0):
    return tgt.clone().index_add_(axis, idx, src)
def _segment_sum(src, seg, n):
    out = torch.zeros((n,) + src.shape[1:], dtype=src.dtype)
    return out.index_add_(0, seg, src)
def _pad(x, pw):
    flat = tuple(v for pair in reversed(pw) for v in pair)
    return torch.nn.functional.pad(x, flat)

kernel_name = 'standalone__linear_kernel_rfa__prompt'

def setup_inputs():

    _w = (lambda a: (lambda t: t.to(torch.bfloat16) if t.is_floating_point() else t)(torch.as_tensor(a)))
    B, H, Sq, Sk, D, M = 1, 32, 2048, 2048, 128, 64
    return {
        "q": _w((lambda *s: torch.randn(*s, dtype=torch.bfloat16) * 0.05)(B, H, Sq, D)),
        "k": _w((lambda *s: torch.randn(*s, dtype=torch.bfloat16) * 0.8)(B, H, Sk, D)),
        "v": _w((lambda *s: torch.randn(*s, dtype=torch.bfloat16) * 0.8)(B, H, Sk, D)),
        "omega": _w((lambda *s: torch.randn(*s, dtype=torch.bfloat16) * 0.8)(M, D)),
    }

def reference(q, k, v, omega):
    d = q.shape[-1]
    m = omega.shape[0]
    scale = float(d) ** -0.25
    qs = q * scale
    ks = k * scale
    q_proj = torch.einsum("bhsd,md->bhsm", qs, omega)
    k_proj = torch.einsum("bhsd,md->bhsm", ks, omega)
    q_sq = 0.5 * torch.einsum("bhsd,bhsd->bhs", qs, qs)[..., None]
    k_sq = 0.5 * torch.einsum("bhsd,bhsd->bhs", ks, ks)[..., None]
    inv_sqrt_m = float(m) ** -0.5
    phi_q = torch.exp(q_proj - q_sq) * inv_sqrt_m + 1e-6
    phi_k = torch.exp(k_proj - k_sq) * inv_sqrt_m + 1e-6
    kv = torch.einsum("bhsm,bhsd->bhmd", phi_k, v)
    z  = torch.einsum("bhsm->bhm", phi_k)
    num = torch.einsum("bhqm,bhmd->bhqd", phi_q, kv)
    den = torch.einsum("bhqm,bhm->bhq", phi_q, z)[..., None] + 1e-6
    return num / den
```

```asm
; @launch grid=(256,1,1) block=(512,1,1) lds=163840
.amdgcn_target "amdgcn-amd-amdhsa--gfx950"
.text
.globl standalone__linear_kernel_rfa__prompt_kernel
.p2align 8
.type standalone__linear_kernel_rfa__prompt_kernel,@function
standalone__linear_kernel_rfa__prompt_kernel:
    s_cmp_ge_u32 s2, 256
    s_cbranch_scc1 L_end
    s_load_dwordx8 s[4:11], s[0:1], 0
    s_load_dwordx4 s[12:15], s[0:1], 32
    s_load_dwordx2 s[16:17], s[0:1], 48
    s_and_b32 s18, s2, 7
    s_lshl_b32 s18, s18, 5
    s_lshr_b32 s19, s2, 3
    s_add_u32 s18, s18, s19
    s_lshr_b32 s20, s18, 3
    s_and_b32 s59, s18, 7
    s_lshl_b32 s19, s18, 16
    v_lshrrev_b32 v1, 6, v0
    v_and_b32 v0, 63, v0
    v_readfirstlane_b32 s22, v1
    v_and_b32 v1, 15, v0
    v_lshrrev_b32 v2, 4, v0
    s_lshl_b32 s58, s22, 12
    v_lshlrev_b32 v3, 8, v1
    v_lshl_add_u32 v3, v2, 4, v3
    s_lshr_b32 s56, s22, 1
    s_lshl_b32 s56, s56, 12
    s_and_b32 s57, s22, 1
    s_lshl_b32 s57, s57, 7
    s_add_u32 s56, s56, s57
    v_add_u32 v3, s56, v3
    v_lshlrev_b32 v4, 8, v2
    v_add_u32 v4, s58, v4
    v_xor_b32 v5, v1, v2
    v_xor_b32 v6, 0, v5
    v_lshl_add_u32 v12, v6, 4, v4
    v_xor_b32 v6, 4, v5
    v_lshl_add_u32 v13, v6, 4, v4
    v_xor_b32 v6, 8, v5
    v_lshl_add_u32 v14, v6, 4, v4
    v_xor_b32 v6, 12, v5
    v_lshl_add_u32 v15, v6, 4, v4
    s_lshl_b32 s2, s22, 11
    s_mov_b32 s3, 0x07060302
    s_mov_b32 s60, 0x100001
    s_mov_b32 s61, 0x10000100
    s_mov_b32 s62, 0x200002
    s_mov_b32 s63, 0x20000200
    s_mov_b32 s64, 0x400004
    s_mov_b32 s65, 0x40000400
    s_mov_b32 s66, 0x800008
    s_mov_b32 s67, 0x80000800
    s_and_b32 s68, s22, 3
    s_lshr_b32 s69, s22, 2
    v_lshlrev_b32 v4, 8, v1
    s_add_u32 s56, s58, 98304
    v_add_u32 v4, s56, v4
    v_xor_b32 v6, 0, v5
    v_lshl_add_u32 v16, v6, 4, v4
    v_xor_b32 v6, 4, v5
    v_lshl_add_u32 v17, v6, 4, v4
    v_xor_b32 v6, 8, v5
    v_lshl_add_u32 v18, v6, 4, v4
    v_xor_b32 v6, 12, v5
    v_lshl_add_u32 v19, v6, 4, v4
    s_and_b32 s56, s22, 1
    s_lshl_b32 s56, s56, 3
    v_lshlrev_b32 v4, 1, v2
    v_add_u32 v4, s56, v4
    v_xor_b32 v4, v4, v1
    v_lshlrev_b32 v4, 4, v4
    v_lshl_add_u32 v4, v2, 8, v4
    s_lshl_b32 s23, s22, 10
    v_add_u32 v24, s23, v4
    v_lshlrev_b32 v4, 10, v2
    v_lshl_add_u32 v4, v1, 4, v4
    v_add_u32 v29, s58, v4
    v_lshlrev_b32 v243, 4, v0
    s_add_u32 s56, s58, 65536
    v_add_u32 v25, s56, v243
    v_add_u32 v26, 49152, v243
    v_mov_b32 v27, 0x358637bd
    v_mov_b32 v28, 0x3d8293ee
    v_mov_b32 v30, 0x3f400000
    v_mov_b32 v232, 0xbf80bf80
    v_mov_b32 v236, 0x3f803f80
    v_mov_b32 v233, 0xbf80bf80
    v_mov_b32 v237, 0x3f803f80
    v_mov_b32 v234, 0xbf80bf80
    v_mov_b32 v238, 0x3f803f80
    v_mov_b32 v235, 0xbf80bf80
    v_mov_b32 v239, 0x3f803f80
    v_mov_b32 v226, 0
    v_mov_b32 v227, 0
    v_mov_b32 v9, 0x3edb9ada
    v_add_u32 v8, s2, v26
    s_waitcnt lgkmcnt(0)
    s_mov_b32 s40, s10
    s_mov_b32 s41, s11
    s_mov_b32 s42, 0x4000
    s_mov_b32 s43, 0x00020000
    s_add_u32 s24, s6, s19
    s_addc_u32 s25, s7, 0
    s_mov_b32 s26, 0x10000
    s_mov_b32 s27, 0x00020000
    buffer_load_dwordx4 v[96:99], v3, s[40:43], 0 offen offset:0
    buffer_load_dwordx4 v[100:103], v3, s[40:43], 0 offen offset:64
    s_mov_b32 s56, 0
    s_add_u32 m0, s58, 98304
    s_nop 0
    buffer_load_dwordx4 v12, s[24:27], s56 offen offset:0 nt lds
    buffer_load_dwordx4 v13, s[24:27], s56 offen offset:1024 nt lds
    buffer_load_dwordx4 v14, s[24:27], s56 offen offset:2048 nt lds
    buffer_load_dwordx4 v15, s[24:27], s56 offen offset:3072 nt lds
    s_add_u32 s28, s8, s19
    s_addc_u32 s29, s9, 0
    s_mov_b32 s30, 0x10000
    s_mov_b32 s31, 0x00020000
    s_add_u32 s32, s4, s19
    s_addc_u32 s33, s5, 0
    s_mov_b32 s34, 0x10000
    s_mov_b32 s35, 0x00020000
    s_add_u32 s36, s12, s19
    s_addc_u32 s37, s13, 0
    s_mov_b32 s38, 0x10000
    s_mov_b32 s39, 0x00020000
    s_mul_i32 s56, s20, 136192
    s_add_u32 s44, s16, s56
    s_addc_u32 s45, s17, 0
    s_mov_b32 s46, 0x21400
    s_mov_b32 s47, 0x00020000
    s_mov_b32 s48, s14
    s_mov_b32 s49, s15
    s_mov_b32 s50, 0x100
    s_mov_b32 s51, 0x00020000
    s_lshl_b32 s56, s20, 2
    v_mov_b32 v10, s56
    s_or_b32 s56, s59, s22
    s_cmp_eq_u32 s56, 0
    s_nop 0
    s_cbranch_scc0 L_noscan1
    v_lshrrev_b32 v6, 3, v0
    v_and_b32 v7, 7, v0
    v_lshlrev_b32 v7, 2, v7
    v_lshl_add_u32 v6, v6, 7, v7
    s_mov_b32 s56, 135168
    buffer_load_dword v11, v6, s[44:47], s56 offen sc1
    s_nop 0
L_noscan1:
    v_lshrrev_b32 v7, 2, v0
    v_and_b32 v4, 7, v7
    v_lshlrev_b32 v4, 1, v4
    v_bfe_u32 v5, v0, 1, 1
    s_lshl_b32 s56, s68, 2
    v_add_u32 v5, s56, v5
    v_xor_b32 v4, v4, v5
    v_lshlrev_b32 v4, 4, v4
    v_lshl_add_u32 v4, v7, 8, v4
    v_and_b32 v5, 1, v0
    v_lshl_add_u32 v20, v5, 3, v4
    v_xor_b32 v21, 32, v20
    v_and_b32 v4, 7, v1
    v_mul_u32_u24 v4, 1056, v4
    v_lshl_add_u32 v4, v2, 8, v4
    v_lshrrev_b32 v5, 3, v1
    v_lshl_add_u32 v4, v5, 4, v4
    s_xor_b32 s56, s68, s59
    s_and_b32 s56, s56, 1
    s_xor_b32 s56, s56, 0
    s_lshl_b32 s57, s69, 1
    s_add_u32 s57, s57, s56
    s_lshl_b32 s57, s57, 10
    s_add_u32 s57, s57, 65536
    v_add_u32 v22, s57, v243
    s_lshl_b32 s56, s56, 3
    s_mul_i32 s57, s69, 9600
    s_add_u32 s56, s56, s57
    s_add_u32 s56, s56, 65536
    v_add_u32 v242, s56, v243
    s_lshl_b32 s57, s68, 6
    s_add_u32 s56, s56, s57
    v_add_u32 v240, s56, v4
    s_xor_b32 s56, s68, s59
    s_and_b32 s56, s56, 1
    s_xor_b32 s56, s56, 1
    s_lshl_b32 s57, s69, 1
    s_add_u32 s57, s57, s56
    s_lshl_b32 s57, s57, 10
    s_add_u32 s57, s57, 65536
    v_add_u32 v23, s57, v243
    s_lshl_b32 s56, s56, 3
    s_mul_i32 s57, s69, 9600
    s_add_u32 s56, s56, s57
    s_add_u32 s56, s56, 65536
    s_lshl_b32 s57, s68, 6
    s_add_u32 s56, s56, s57
    v_add_u32 v241, s56, v4
    v_mov_b32 v244, 0
    v_mov_b32 v245, 0
    v_mov_b32 v250, 0
    v_mov_b32 v251, 0
    v_mov_b32 v4, 0x3f80
    v_mov_b32 v5, 0x3f800000
    v_cndmask_b32 v246, 0, v4, s[60:61]
    v_cndmask_b32 v246, v246, v5, s[62:63]
    v_cndmask_b32 v247, 0, v4, s[64:65]
    v_cndmask_b32 v247, v247, v5, s[66:67]
    v_mov_b32 v248, v246
    v_mov_b32 v249, v247
    v_and_b32 v4, 7, v1
    v_mul_u32_u24 v4, 16896, v4
    v_lshlrev_b32 v1, 4, v2
    v_add_u32 v2, v4, v1
    s_mul_i32 s56, s59, 16896
    s_add_u32 s0, s56, s2
    s_add_u32 s57, s59, 1
    s_and_b32 s57, s57, 7
    s_mul_i32 s57, s57, 16896
    s_add_u32 s4, s57, s2
    s_add_u32 s57, s59, 2
    s_and_b32 s57, s57, 7
    s_mul_i32 s57, s57, 16896
    s_add_u32 s5, s57, s2
    s_add_u32 s57, s59, 3
    s_and_b32 s57, s57, 7
    s_mul_i32 s57, s57, 16896
    s_add_u32 s6, s57, s2
    s_add_u32 s57, s59, 4
    s_and_b32 s57, s57, 7
    s_mul_i32 s57, s57, 16896
    s_add_u32 s7, s57, s2
    s_add_u32 s57, s59, 5
    s_and_b32 s57, s57, 7
    s_mul_i32 s57, s57, 16896
    s_add_u32 s8, s57, s2
    s_add_u32 s57, s59, 6
    s_and_b32 s57, s57, 7
    s_mul_i32 s57, s57, 16896
    s_add_u32 s9, s57, s2
    s_add_u32 s57, s59, 7
    s_and_b32 s57, s57, 7
    s_mul_i32 s57, s57, 16896
    s_add_u32 s10, s57, s2
    s_and_b32 s21, s59, 1
    s_xor_b32 s21, s21, s22
    s_lshl_b32 s21, s21, 6
    s_add_u32 s21, s21, 16384
    s_add_u32 s1, s21, s56
    s_lshl_b32 s16, s22, 7
    s_add_u32 s16, s16, 135168
    s_lshl_b32 s17, s59, 2
    s_add_u32 s17, s17, s16
    v_mov_b32 v3, 0xffff0000
    s_waitcnt vmcnt(4)
    v_lshlrev_b32 v4, 16, v96
    v_and_b32 v5, v3, v96
    v_mul_f32 v4, v9, v4
    v_mul_f32 v5, v9, v5
    v_cvt_pk_bf16_f32 v104, v4, v5
    v_lshlrev_b32 v4, 16, v97
    v_and_b32 v5, v3, v97
    v_mul_f32 v4, v9, v4
    v_mul_f32 v5, v9, v5
    v_cvt_pk_bf16_f32 v105, v4, v5
    v_lshlrev_b32 v4, 16, v98
    v_and_b32 v5, v3, v98
    v_mul_f32 v4, v9, v4
    v_mul_f32 v5, v9, v5
    v_cvt_pk_bf16_f32 v106, v4, v5
    v_lshlrev_b32 v4, 16, v99
    v_and_b32 v5, v3, v99
    v_mul_f32 v4, v9, v4
    v_mul_f32 v5, v9, v5
    v_cvt_pk_bf16_f32 v107, v4, v5
    v_lshlrev_b32 v4, 16, v100
    v_and_b32 v5, v3, v100
    v_mul_f32 v4, v9, v4
    v_mul_f32 v5, v9, v5
    v_cvt_pk_bf16_f32 v108, v4, v5
    v_lshlrev_b32 v4, 16, v101
    v_and_b32 v5, v3, v101
    v_mul_f32 v4, v9, v4
    v_mul_f32 v5, v9, v5
    v_cvt_pk_bf16_f32 v109, v4, v5
    v_lshlrev_b32 v4, 16, v102
    v_and_b32 v5, v3, v102
    v_mul_f32 v4, v9, v4
    v_mul_f32 v5, v9, v5
    v_cvt_pk_bf16_f32 v110, v4, v5
    v_lshlrev_b32 v4, 16, v103
    v_and_b32 v5, v3, v103
    v_mul_f32 v4, v9, v4
    v_mul_f32 v5, v9, v5
    v_cvt_pk_bf16_f32 v111, v4, v5
    ds_write_b128 v8, v[104:107]
    ds_write_b128 v8, v[108:111] offset:1024
    s_mov_b32 s56, 32768
    s_add_u32 m0, s58, 131072
    s_nop 0
    buffer_load_dwordx4 v12, s[24:27], s56 offen offset:0 nt lds
    buffer_load_dwordx4 v13, s[24:27], s56 offen offset:1024 nt lds
    s_waitcnt lgkmcnt(0)
    s_barrier
    ds_read_b128 v[32:35], v26 offset:0
    ds_read_b128 v[36:39], v26 offset:1024
    ds_read_b128 v[40:43], v26 offset:2048
    ds_read_b128 v[44:47], v26 offset:3072
    ds_read_b128 v[48:51], v26 offset:4096
    ds_read_b128 v[52:55], v26 offset:5120
    ds_read_b128 v[56:59], v26 offset:6144
    ds_read_b128 v[60:63], v26 offset:7168
    ds_read_b128 v[64:67], v26 offset:8192
    ds_read_b128 v[68:71], v26 offset:9216
    ds_read_b128 v[72:75], v26 offset:10240
    ds_read_b128 v[76:79], v26 offset:11264
    ds_read_b128 v[80:83], v26 offset:12288
    ds_read_b128 v[84:87], v26 offset:13312
    ds_read_b128 v[88:91], v26 offset:14336
    ds_read_b128 v[92:95], v26 offset:15360
    s_mov_b32 s56, 32768
    s_add_u32 m0, s58, 131072
    s_nop 0
    buffer_load_dwordx4 v14, s[24:27], s56 offen offset:2048 nt lds
    buffer_load_dwordx4 v15, s[24:27], s56 offen offset:3072 nt lds
    s_waitcnt vmcnt(4)
    ds_read_b128 v[96:99], v16 offset:0
    ds_read_b128 v[100:103], v17 offset:0
    ds_read_b128 v[104:107], v18 offset:0
    ds_read_b128 v[108:111], v19 offset:0
    s_waitcnt lgkmcnt(0)
    s_or_b32 s56, s59, s22
    s_cmp_eq_u32 s56, 0
    s_cbranch_scc0 L_noscan2
    s_mov_b32 s15, 0
    s_waitcnt vmcnt(4)
L_scan:
    s_add_u32 s15, s15, 1
    v_cmp_eq_u32 vcc, s15, v11
    s_nop 4
    s_cbranch_vccnz L_scan
    v_mov_b32 v11, s15
    s_mov_b64 exec, 1
    buffer_store_dword v11, v10, s[48:51], 0 offen sc1
    s_mov_b64 exec, -1
L_noscan2:
    v_mfma_f32_16x16x32_bf16 v[128:131], v[96:99], v[96:99], 0
    v_mfma_f32_16x16x32_bf16 v[128:131], v[100:103], v[100:103], v[128:131]
    v_mfma_f32_16x16x32_bf16 v[128:131], v[104:107], v[104:107], v[128:131]
    v_mfma_f32_16x16x32_bf16 v[128:131], v[108:111], v[108:111], v[128:131]
    s_nop 7
    v_cndmask_b32 v4, 0, v128, s[60:61]
    v_cndmask_b32 v4, v4, v129, s[62:63]
    v_cndmask_b32 v4, v4, v130, s[64:65]
    v_cndmask_b32 v4, v4, v131, s[66:67]
    v_fma_f32 v4, v4, v28, v30
    v_and_b32 v5, v3, v4
    v_sub_f32 v5, v4, v5
    v_and_b32 v6, v3, v5
    v_perm_b32 v224, v5, v4, s3
    v_sub_f32 v6, v5, v6
    v_lshrrev_b32 v225, 16, v6
    s_nop 1
    v_mfma_f32_16x16x32_bf16 v[228:231], v[224:227], v[232:235], 0
    v_mfma_f32_16x16x32_bf16 v[112:115], v[96:99], v[32:35], v[228:231]
    v_mfma_f32_16x16x32_bf16 v[112:115], v[100:103], v[36:39], v[112:115]
    v_mfma_f32_16x16x32_bf16 v[112:115], v[104:107], v[40:43], v[112:115]
    v_mfma_f32_16x16x32_bf16 v[112:115], v[108:111], v[44:47], v[112:115]
    v_mfma_f32_16x16x32_bf16 v[116:119], v[96:99], v[48:51], v[228:231]
    v_mfma_f32_16x16x32_bf16 v[116:119], v[100:103], v[52:55], v[116:119]
    v_mfma_f32_16x16x32_bf16 v[116:119], v[104:107], v[56:59], v[116:119]
    v_mfma_f32_16x16x32_bf16 v[116:119], v[108:111], v[60:63], v[116:119]
    v_mfma_f32_16x16x32_bf16 v[120:123], v[96:99], v[64:67], v[228:231]
    s_nop 2
    v_exp_f32 v112, v112
    v_mfma_f32_16x16x32_bf16 v[120:123], v[100:103], v[68:71], v[120:123]
    v_exp_f32 v113, v113
    v_mfma_f32_16x16x32_bf16 v[120:123], v[104:107], v[72:75], v[120:123]
    v_exp_f32 v114, v114
    v_mfma_f32_16x16x32_bf16 v[120:123], v[108:111], v[76:79], v[120:123]
    v_exp_f32 v115, v115
    v_mfma_f32_16x16x32_bf16 v[124:127], v[96:99], v[80:83], v[228:231]
    v_add_f32 v112, v27, v112
    v_add_f32 v113, v27, v113
    v_mfma_f32_16x16x32_bf16 v[124:127], v[100:103], v[84:87], v[124:127]
    v_add_f32 v114, v27, v114
    v_add_f32 v115, v27, v115
    v_mfma_f32_16x16x32_bf16 v[124:127], v[104:107], v[88:91], v[124:127]
    v_cvt_pk_bf16_f32 v6, v112, v113
    v_cvt_pk_bf16_f32 v7, v114, v115
    v_mfma_f32_16x16x32_bf16 v[124:127], v[108:111], v[92:95], v[124:127]
    ds_write_b64 v25, v[6:7] offset:0
    v_exp_f32 v116, v116
    v_exp_f32 v117, v117
    v_exp_f32 v118, v118
    v_exp_f32 v119, v119
    v_add_f32 v116, v27, v116
    v_add_f32 v117, v27, v117
    v_add_f32 v118, v27, v118
    v_add_f32 v119, v27, v119
    v_cvt_pk_bf16_f32 v8, v116, v117
    v_cvt_pk_bf16_f32 v9, v118, v119
    ds_write_b64 v25, v[8:9] offset:1024
    v_exp_f32 v120, v120
    v_exp_f32 v121, v121
    v_exp_f32 v122, v122
    v_exp_f32 v123, v123
    v_add_f32 v120, v27, v120
    v_add_f32 v121, v27, v121
    v_add_f32 v122, v27, v122
    v_add_f32 v123, v27, v123
    v_cvt_pk_bf16_f32 v6, v120, v121
    v_cvt_pk_bf16_f32 v7, v122, v123
    ds_write_b64 v25, v[6:7] offset:2048
    v_exp_f32 v124, v124
    v_exp_f32 v125, v125
    v_exp_f32 v126, v126
    v_exp_f32 v127, v127
    v_add_f32 v124, v27, v124
    v_add_f32 v125, v27, v125
    v_add_f32 v126, v27, v126
    v_add_f32 v127, v27, v127
    v_cvt_pk_bf16_f32 v8, v124, v125
    v_cvt_pk_bf16_f32 v9, v126, v127
    ds_write_b64 v25, v[8:9] offset:3072
    s_mov_b32 s56, 0
    s_add_u32 m0, s23, 0
    s_nop 0
    buffer_load_dwordx4 v24, s[28:31], s56 offen nt lds
    s_mov_b32 s56, 32768
    s_add_u32 m0, s23, 32768
    s_nop 0
    buffer_load_dwordx4 v24, s[28:31], s56 offen nt lds
    s_mov_b32 s56, 8192
    s_add_u32 m0, s23, 8192
    s_nop 0
    buffer_load_dwordx4 v24, s[28:31], s56 offen nt lds
    s_waitcnt vmcnt(3)
    ds_read_b128 v[96:99], v16 offset:32768
    ds_read_b128 v[100:103], v17 offset:32768
    ds_read_b128 v[104:107], v18 offset:32768
    ds_read_b128 v[108:111], v19 offset:32768
    s_waitcnt lgkmcnt(0)
    v_mfma_f32_16x16x32_bf16 v[128:131], v[96:99], v[96:99], 0
    v_mfma_f32_16x16x32_bf16 v[128:131], v[100:103], v[100:103], v[128:131]
    v_mfma_f32_16x16x32_bf16 v[128:131], v[104:107], v[104:107], v[128:131]
    v_mfma_f32_16x16x32_bf16 v[128:131], v[108:111], v[108:111], v[128:131]
    s_nop 7
    v_cndmask_b32 v4, 0, v128, s[60:61]
    v_cndmask_b32 v4, v4, v129, s[62:63]
    v_cndmask_b32 v4, v4, v130, s[64:65]
    v_cndmask_b32 v4, v4, v131, s[66:67]
    v_fma_f32 v4, v4, v28, v30
    v_and_b32 v5, v3, v4
    v_sub_f32 v5, v4, v5
    v_and_b32 v6, v3, v5
    v_perm_b32 v224, v5, v4, s3
    v_sub_f32 v6, v5, v6
    v_lshrrev_b32 v225, 16, v6
    s_nop 1
    v_mfma_f32_16x16x32_bf16 v[228:231], v[224:227], v[232:235], 0
    s_mov_b32 s56, 40960
    s_add_u32 m0, s23, 40960
    s_nop 0
    buffer_load_dwordx4 v24, s[28:31], s56 offen nt lds
    v_mfma_f32_16x16x32_bf16 v[112:115], v[96:99], v[32:35], v[228:231]
    v_mfma_f32_16x16x32_bf16 v[112:115], v[100:103], v[36:39], v[112:115]
    v_mfma_f32_16x16x32_bf16 v[112:115], v[104:107], v[40:43], v[112:115]
    v_mfma_f32_16x16x32_bf16 v[112:115], v[108:111], v[44:47], v[112:115]
    v_mfma_f32_16x16x32_bf16 v[116:119], v[96:99], v[48:51], v[228:231]
    v_mfma_f32_16x16x32_bf16 v[116:119], v[100:103], v[52:55], v[116:119]
    v_mfma_f32_16x16x32_bf16 v[116:119], v[104:107], v[56:59], v[116:119]
    v_mfma_f32_16x16x32_bf16 v[116:119], v[108:111], v[60:63], v[116:119]
    v_mfma_f32_16x16x32_bf16 v[120:123], v[96:99], v[64:67], v[228:231]
    s_nop 2
    v_exp_f32 v112, v112
    v_mfma_f32_16x16x32_bf16 v[120:123], v[100:103], v[68:71], v[120:123]
    v_exp_f32 v113, v113
    v_mfma_f32_16x16x32_bf16 v[120:123], v[104:107], v[72:75], v[120:123]
    v_exp_f32 v114, v114
    v_mfma_f32_16x16x32_bf16 v[120:123], v[108:111], v[76:79], v[120:123]
    v_exp_f32 v115, v115
    v_mfma_f32_16x16x32_bf16 v[124:127], v[96:99], v[80:83], v[228:231]
    v_add_f32 v112, v27, v112
    v_add_f32 v113, v27, v113
    v_mfma_f32_16x16x32_bf16 v[124:127], v[100:103], v[84:87], v[124:127]
    v_add_f32 v114, v27, v114
    v_add_f32 v115, v27, v115
    v_mfma_f32_16x16x32_bf16 v[124:127], v[104:107], v[88:91], v[124:127]
    v_cvt_pk_bf16_f32 v6, v112, v113
    v_cvt_pk_bf16_f32 v7, v114, v115
    v_mfma_f32_16x16x32_bf16 v[124:127], v[108:111], v[92:95], v[124:127]
    ds_write_b64 v25, v[6:7] offset:8
    v_exp_f32 v116, v116
    v_exp_f32 v117, v117
    v_exp_f32 v118, v118
    v_exp_f32 v119, v119
    v_add_f32 v116, v27, v116
    v_add_f32 v117, v27, v117
    v_add_f32 v118, v27, v118
    v_add_f32 v119, v27, v119
    v_cvt_pk_bf16_f32 v8, v116, v117
    v_cvt_pk_bf16_f32 v9, v118, v119
    ds_write_b64 v25, v[8:9] offset:1032
    s_mov_b32 s56, 16384
    s_add_u32 m0, s23, 16384
    s_nop 0
    buffer_load_dwordx4 v24, s[28:31], s56 offen nt lds
    v_exp_f32 v120, v120
    v_exp_f32 v121, v121
    v_exp_f32 v122, v122
    v_exp_f32 v123, v123
    v_add_f32 v120, v27, v120
    v_add_f32 v121, v27, v121
    v_add_f32 v122, v27, v122
    v_add_f32 v123, v27, v123
    v_cvt_pk_bf16_f32 v6, v120, v121
    v_cvt_pk_bf16_f32 v7, v122, v123
    ds_write_b64 v25, v[6:7] offset:2056
    v_exp_f32 v124, v124
    v_exp_f32 v125, v125
    v_exp_f32 v126, v126
    v_exp_f32 v127, v127
    v_add_f32 v124, v27, v124
    v_add_f32 v125, v27, v125
    v_add_f32 v126, v27, v126
    v_add_f32 v127, v27, v127
    v_cvt_pk_bf16_f32 v8, v124, v125
    v_cvt_pk_bf16_f32 v9, v126, v127
    ds_write_b64 v25, v[8:9] offset:3080
    s_waitcnt lgkmcnt(0)
    s_barrier
    ds_read_b128 v[132:135], v22 offset:0
    ds_read_b128 v[136:139], v23 offset:0
    ds_read_b128 v[140:143], v22 offset:4096
    ds_read_b128 v[144:147], v23 offset:4096
    ds_read_b128 v[148:151], v22 offset:8192
    ds_read_b128 v[152:155], v23 offset:8192
    ds_read_b128 v[156:159], v22 offset:12288
    ds_read_b128 v[160:163], v23 offset:12288
    ds_read_b128 v[164:167], v22 offset:16384
    ds_read_b128 v[168:171], v23 offset:16384
    ds_read_b128 v[172:175], v22 offset:20480
    ds_read_b128 v[176:179], v23 offset:20480
    ds_read_b128 v[180:183], v22 offset:24576
    ds_read_b128 v[184:187], v23 offset:24576
    ds_read_b128 v[188:191], v22 offset:28672
    ds_read_b128 v[192:195], v23 offset:28672
    s_mov_b32 s56, 49152
    s_add_u32 m0, s23, 49152
    s_nop 0
    buffer_load_dwordx4 v24, s[28:31], s56 offen nt lds
    s_waitcnt lgkmcnt(14)
    v_mfma_f32_16x16x32_bf16 v[220:223], v[132:135], v[236:239], 0
    s_waitcnt lgkmcnt(13)
    v_mfma_f32_16x16x32_bf16 v[220:223], v[140:143], v[236:239], v[220:223]
    s_waitcnt lgkmcnt(11)
    v_mfma_f32_16x16x32_bf16 v[220:223], v[148:151], v[236:239], v[220:223]
    s_waitcnt lgkmcnt(9)
    v_mfma_f32_16x16x32_bf16 v[220:223], v[156:159], v[236:239], v[220:223]
    s_waitcnt lgkmcnt(7)
    v_mfma_f32_16x16x32_bf16 v[220:223], v[164:167], v[236:239], v[220:223]
    s_waitcnt lgkmcnt(5)
    v_mfma_f32_16x16x32_bf16 v[220:223], v[172:175], v[236:239], v[220:223]
    s_waitcnt lgkmcnt(3)
    v_mfma_f32_16x16x32_bf16 v[220:223], v[180:183], v[236:239], v[220:223]
    s_waitcnt lgkmcnt(1)
    v_mfma_f32_16x16x32_bf16 v[220:223], v[188:191], v[236:239], v[220:223]
    s_mov_b32 s56, 24576
    s_add_u32 m0, s23, 24576
    s_nop 0
    buffer_load_dwordx4 v24, s[28:31], s56 offen nt lds
    s_mov_b32 s56, 57344
    s_add_u32 m0, s23, 57344
    s_nop 0
    buffer_load_dwordx4 v24, s[28:31], s56 offen nt lds
    buffer_store_dwordx4 v[220:223], v1, s[44:47], s1 offen sc1
    s_waitcnt vmcnt(5) lgkmcnt(0)
    s_barrier
    s_cmp_eq_u32 s22, 0
    s_cbranch_scc0 L_nofetch
    buffer_load_dword v31, v10, s[48:51], 0 offen sc1
L_nofetch:
    ds_read_b64_tr_b16 v[96:97], v20 offset:0
    ds_read_b64_tr_b16 v[98:99], v20 offset:32768
    ds_read_b64_tr_b16 v[100:101], v21 offset:0
    ds_read_b64_tr_b16 v[102:103], v21 offset:32768
    ds_read_b64_tr_b16 v[104:105], v20 offset:4096
    ds_read_b64_tr_b16 v[106:107], v20 offset:36864
    ds_read_b64_tr_b16 v[108:109], v21 offset:4096
    ds_read_b64_tr_b16 v[110:111], v21 offset:36864
    ds_read_b64_tr_b16 v[112:113], v20 offset:8192
    ds_read_b64_tr_b16 v[114:115], v20 offset:40960
    ds_read_b64_tr_b16 v[116:117], v21 offset:8192
    ds_read_b64_tr_b16 v[118:119], v21 offset:40960
    ds_read_b64_tr_b16 v[120:121], v20 offset:12288
    ds_read_b64_tr_b16 v[122:123], v20 offset:45056
    ds_read_b64_tr_b16 v[124:125], v21 offset:12288
    ds_read_b64_tr_b16 v[126:127], v21 offset:45056
    s_waitcnt lgkmcnt(14)
    v_mfma_f32_16x16x32_bf16 v[204:207], v[132:135], v[96:99], 0
    v_mfma_f32_16x16x32_bf16 v[208:211], v[136:139], v[96:99], 0
    s_waitcnt lgkmcnt(12)
    v_mfma_f32_16x16x32_bf16 v[212:215], v[132:135], v[100:103], 0
    v_mfma_f32_16x16x32_bf16 v[216:219], v[136:139], v[100:103], 0
    s_waitcnt lgkmcnt(10)
    v_mfma_f32_16x16x32_bf16 v[204:207], v[140:143], v[104:107], v[204:207]
    v_mfma_f32_16x16x32_bf16 v[208:211], v[144:147], v[104:107], v[208:211]
    s_waitcnt lgkmcnt(8)
    v_mfma_f32_16x16x32_bf16 v[212:215], v[140:143], v[108:111], v[212:215]
    v_mfma_f32_16x16x32_bf16 v[216:219], v[144:147], v[108:111], v[216:219]
    s_waitcnt lgkmcnt(6)
    v_mfma_f32_16x16x32_bf16 v[204:207], v[148:151], v[112:115], v[204:207]
    v_mfma_f32_16x16x32_bf16 v[208:211], v[152:155], v[112:115], v[208:211]
    s_waitcnt lgkmcnt(4)
    v_mfma_f32_16x16x32_bf16 v[212:215], v[148:151], v[116:119], v[212:215]
    v_mfma_f32_16x16x32_bf16 v[216:219], v[152:155], v[116:119], v[216:219]
    s_waitcnt lgkmcnt(2)
    v_mfma_f32_16x16x32_bf16 v[204:207], v[156:159], v[120:123], v[204:207]
    v_mfma_f32_16x16x32_bf16 v[208:211], v[160:163], v[120:123], v[208:211]
    s_waitcnt lgkmcnt(0)
    v_mfma_f32_16x16x32_bf16 v[212:215], v[156:159], v[124:127], v[212:215]
    v_mfma_f32_16x16x32_bf16 v[216:219], v[160:163], v[124:127], v[216:219]
    s_mov_b32 s56, 0
    s_add_u32 m0, s58, 98304
    s_nop 0
    buffer_load_dwordx4 v12, s[32:35], s56 offen offset:0 nt lds
    s_waitcnt vmcnt(4)
    s_barrier
    ds_read_b64_tr_b16 v[96:97], v20 offset:16384
    ds_read_b64_tr_b16 v[98:99], v20 offset:49152
    ds_read_b64_tr_b16 v[100:101], v21 offset:16384
    ds_read_b64_tr_b16 v[102:103], v21 offset:49152
    ds_read_b64_tr_b16 v[104:105], v20 offset:20480
    ds_read_b64_tr_b16 v[106:107], v20 offset:53248
    ds_read_b64_tr_b16 v[108:109], v21 offset:20480
    ds_read_b64_tr_b16 v[110:111], v21 offset:53248
    s_waitcnt lgkmcnt(6)
    v_mfma_f32_16x16x32_bf16 v[204:207], v[164:167], v[96:99], v[204:207]
    v_mfma_f32_16x16x32_bf16 v[208:211], v[168:171], v[96:99], v[208:211]
    s_waitcnt lgkmcnt(4)
    v_mfma_f32_16x16x32_bf16 v[212:215], v[164:167], v[100:103], v[212:215]
    v_mfma_f32_16x16x32_bf16 v[216:219], v[168:171], v[100:103], v[216:219]
    s_waitcnt lgkmcnt(2)
    v_mfma_f32_16x16x32_bf16 v[204:207], v[172:175], v[104:107], v[204:207]
    v_mfma_f32_16x16x32_bf16 v[208:211], v[176:179], v[104:107], v[208:211]
    s_waitcnt lgkmcnt(0)
    v_mfma_f32_16x16x32_bf16 v[212:215], v[172:175], v[108:111], v[212:215]
    v_mfma_f32_16x16x32_bf16 v[216:219], v[176:179], v[108:111], v[216:219]
    s_mov_b32 s56, 0
    s_add_u32 m0, s58, 98304
    s_nop 0
    buffer_load_dwordx4 v13, s[32:35], s56 offen offset:1024 nt lds
    buffer_load_dwordx4 v14, s[32:35], s56 offen offset:2048 nt lds
    s_cmp_eq_u32 s22, 0
    s_nop 1
    s_cbranch_scc0 L_non_done
    s_mov_b32 s14, 0x10000
    s_waitcnt vmcnt(3)
L_non:
    v_readfirstlane_b32 s15, v31
    s_nop 0
    s_cmp_lg_u32 s15, 0
    s_nop 2
    s_cbranch_scc1 L_non_ok
    s_sleep 1
    buffer_load_dword v31, v10, s[48:51], 0 offen sc1
    s_waitcnt vmcnt(0)
    s_sub_u32 s14, s14, 1
    s_cmp_lg_u32 s14, 0
    s_cbranch_scc1 L_non
L_non_ok:
    v_mov_b32 v4, 86016
    ds_write_b32 v4, v31
    s_nop 1
L_non_done:
    s_waitcnt vmcnt(3) lgkmcnt(0)
    s_barrier
    v_mov_b32 v4, 86016
    ds_read_b32 v31, v4
    ds_read_b64_tr_b16 v[96:97], v20 offset:24576
    ds_read_b64_tr_b16 v[98:99], v20 offset:57344
    ds_read_b64_tr_b16 v[100:101], v21 offset:24576
    ds_read_b64_tr_b16 v[102:103], v21 offset:57344
    ds_read_b64_tr_b16 v[104:105], v20 offset:28672
    ds_read_b64_tr_b16 v[106:107], v20 offset:61440
    ds_read_b64_tr_b16 v[108:109], v21 offset:28672
    ds_read_b64_tr_b16 v[110:111], v21 offset:61440
    s_waitcnt lgkmcnt(6)
    v_mfma_f32_16x16x32_bf16 v[204:207], v[180:183], v[96:99], v[204:207]
    v_mfma_f32_16x16x32_bf16 v[208:211], v[184:187], v[96:99], v[208:211]
    s_waitcnt lgkmcnt(4)
    v_mfma_f32_16x16x32_bf16 v[212:215], v[180:183], v[100:103], v[212:215]
    v_mfma_f32_16x16x32_bf16 v[216:219], v[184:187], v[100:103], v[216:219]
    s_waitcnt lgkmcnt(2)
    v_mfma_f32_16x16x32_bf16 v[204:207], v[188:191], v[104:107], v[204:207]
    v_mfma_f32_16x16x32_bf16 v[208:211], v[192:195], v[104:107], v[208:211]
    s_waitcnt lgkmcnt(0)
    v_mfma_f32_16x16x32_bf16 v[212:215], v[188:191], v[108:111], v[212:215]
    v_mfma_f32_16x16x32_bf16 v[216:219], v[192:195], v[108:111], v[216:219]
    s_nop 3
    v_cvt_pk_bf16_f32 v196, v204, v205
    v_cvt_pk_bf16_f32 v197, v206, v207
    v_cvt_pk_bf16_f32 v198, v208, v209
    v_cvt_pk_bf16_f32 v199, v210, v211
    buffer_store_dwordx4 v[196:199], v243, s[44:47], s0 offen offset:0 sc1
    v_cvt_pk_bf16_f32 v200, v212, v213
    v_cvt_pk_bf16_f32 v201, v214, v215
    v_cvt_pk_bf16_f32 v202, v216, v217
    v_cvt_pk_bf16_f32 v203, v218, v219
    buffer_store_dwordx4 v[200:203], v243, s[44:47], s0 offen offset:1024 sc1
    v_readfirstlane_b32 s15, v31
    s_mov_b32 s56, 0
    s_add_u32 m0, s58, 98304
    s_nop 0
    buffer_load_dwordx4 v15, s[32:35], s56 offen offset:3072 nt lds
    s_mov_b32 s56, 32768
    s_add_u32 m0, s58, 131072
    s_nop 0
    buffer_load_dwordx4 v12, s[32:35], s56 offen offset:0 nt lds
    buffer_load_dwordx4 v13, s[32:35], s56 offen offset:1024 nt lds
    s_mov_b32 s12, s15
    s_waitcnt vmcnt(3) lgkmcnt(0)
    s_atomic_swap s12, s[44:45], s17
    s_mov_b32 s56, 32768
    s_add_u32 m0, s58, 131072
    s_nop 0
    buffer_load_dwordx4 v14, s[32:35], s56 offen offset:2048 nt lds
    buffer_load_dwordx4 v15, s[32:35], s56 offen offset:3072 nt lds
    s_waitcnt vmcnt(4)
    ds_read_b128 v[96:99], v16 offset:0
    ds_read_b128 v[100:103], v17 offset:0
    ds_read_b128 v[104:107], v18 offset:0
    ds_read_b128 v[108:111], v19 offset:0
    s_waitcnt lgkmcnt(0)
    v_mfma_f32_16x16x32_bf16 v[128:131], v[96:99], v[96:99], 0
    v_mfma_f32_16x16x32_bf16 v[128:131], v[100:103], v[100:103], v[128:131]
    v_mfma_f32_16x16x32_bf16 v[128:131], v[104:107], v[104:107], v[128:131]
    v_mfma_f32_16x16x32_bf16 v[128:131], v[108:111], v[108:111], v[128:131]
    s_nop 7
    v_cndmask_b32 v4, 0, v128, s[60:61]
    v_cndmask_b32 v4, v4, v129, s[62:63]
    v_cndmask_b32 v4, v4, v130, s[64:65]
    v_cndmask_b32 v4, v4, v131, s[66:67]
    v_fma_f32 v4, v4, v28, v30
    v_and_b32 v5, v3, v4
    v_sub_f32 v5, v4, v5
    v_and_b32 v6, v3, v5
    v_perm_b32 v224, v5, v4, s3
    v_sub_f32 v6, v5, v6
    v_lshrrev_b32 v225, 16, v6
    s_nop 1
    v_mfma_f32_16x16x32_bf16 v[228:231], v[232:235], v[224:227], 0
    v_mfma_f32_16x16x32_bf16 v[112:115], v[32:35], v[96:99], v[228:231]
    v_mfma_f32_16x16x32_bf16 v[112:115], v[36:39], v[100:103], v[112:115]
    v_mfma_f32_16x16x32_bf16 v[112:115], v[40:43], v[104:107], v[112:115]
    v_mfma_f32_16x16x32_bf16 v[112:115], v[44:47], v[108:111], v[112:115]
    v_mfma_f32_16x16x32_bf16 v[116:119], v[48:51], v[96:99], v[228:231]
    v_mfma_f32_16x16x32_bf16 v[116:119], v[52:55], v[100:103], v[116:119]
    v_mfma_f32_16x16x32_bf16 v[116:119], v[56:59], v[104:107], v[116:119]
    v_mfma_f32_16x16x32_bf16 v[116:119], v[60:63], v[108:111], v[116:119]
    v_mfma_f32_16x16x32_bf16 v[120:123], v[64:67], v[96:99], v[228:231]
    s_nop 2
    v_exp_f32 v112, v112
    v_mfma_f32_16x16x32_bf16 v[120:123], v[68:71], v[100:103], v[120:123]
    v_exp_f32 v113, v113
    v_mfma_f32_16x16x32_bf16 v[120:123], v[72:75], v[104:107], v[120:123]
    v_exp_f32 v114, v114
    v_mfma_f32_16x16x32_bf16 v[120:123], v[76:79], v[108:111], v[120:123]
    v_exp_f32 v115, v115
    v_mfma_f32_16x16x32_bf16 v[124:127], v[80:83], v[96:99], v[228:231]
    v_add_f32 v112, v27, v112
    v_add_f32 v113, v27, v113
    v_mfma_f32_16x16x32_bf16 v[124:127], v[84:87], v[100:103], v[124:127]
    v_add_f32 v114, v27, v114
    v_add_f32 v115, v27, v115
    v_mfma_f32_16x16x32_bf16 v[124:127], v[88:91], v[104:107], v[124:127]
    v_cvt_pk_bf16_f32 v132, v112, v113
    v_cvt_pk_bf16_f32 v133, v114, v115
    v_mfma_f32_16x16x32_bf16 v[124:127], v[92:95], v[108:111], v[124:127]
    v_exp_f32 v116, v116
    v_exp_f32 v117, v117
    v_exp_f32 v118, v118
    v_exp_f32 v119, v119
    v_add_f32 v116, v27, v116
    v_add_f32 v117, v27, v117
    v_add_f32 v118, v27, v118
    v_add_f32 v119, v27, v119
    v_cvt_pk_bf16_f32 v134, v116, v117
    v_cvt_pk_bf16_f32 v135, v118, v119
    v_exp_f32 v120, v120
    v_exp_f32 v121, v121
    v_exp_f32 v122, v122
    v_exp_f32 v123, v123
    v_add_f32 v120, v27, v120
    v_add_f32 v121, v27, v121
    v_add_f32 v122, v27, v122
    v_add_f32 v123, v27, v123
    v_cvt_pk_bf16_f32 v136, v120, v121
    v_cvt_pk_bf16_f32 v137, v122, v123
    v_exp_f32 v124, v124
    v_exp_f32 v125, v125
    v_exp_f32 v126, v126
    v_exp_f32 v127, v127
    v_add_f32 v124, v27, v124
    v_add_f32 v125, v27, v125
    v_add_f32 v126, v27, v126
    v_add_f32 v127, v27, v127
    v_cvt_pk_bf16_f32 v138, v124, v125
    v_cvt_pk_bf16_f32 v139, v126, v127
    s_mov_b32 s14, 0x10000
    s_nop 1
L_poll:
    s_load_dwordx8 s[24:31], s[44:45], s16 glc
    s_waitcnt lgkmcnt(0)
    s_and_b64 s[40:41], s[24:25], s[26:27]
    s_and_b64 s[42:43], s[28:29], s[30:31]
    s_or_b64 s[24:25], s[24:25], s[26:27]
    s_or_b64 s[28:29], s[28:29], s[30:31]
    s_and_b64 s[40:41], s[40:41], s[42:43]
    s_or_b64 s[24:25], s[24:25], s[28:29]
    s_and_b32 s40, s40, s41
    s_or_b32 s24, s24, s25
    s_xor_b32 s40, s40, s15
    s_xor_b32 s24, s24, s15
    s_or_b32 s24, s24, s40
    s_cbranch_scc0 L_poll_done
    s_sleep 1
    s_sub_u32 s14, s14, 1
    s_cmp_lg_u32 s14, 0
    s_cbranch_scc1 L_poll
L_poll_done:
    buffer_load_dwordx4 v[236:239], v2, s[44:47], s21 offen sc1
    buffer_load_dwordx4 v[148:151], v243, s[44:47], s4 offen offset:0 sc1
    buffer_load_dwordx4 v[176:179], v243, s[44:47], s4 offen offset:1024 sc1
    buffer_load_dwordx4 v[152:155], v243, s[44:47], s5 offen offset:0 sc1
    buffer_load_dwordx4 v[180:183], v243, s[44:47], s5 offen offset:1024 sc1
    s_waitcnt vmcnt(5)
    ds_read_b128 v[96:99], v16 offset:32768
    ds_read_b128 v[100:103], v17 offset:32768
    ds_read_b128 v[104:107], v18 offset:32768
    ds_read_b128 v[108:111], v19 offset:32768
    s_waitcnt lgkmcnt(0)
    v_mfma_f32_16x16x32_bf16 v[128:131], v[96:99], v[96:99], 0
    v_mfma_f32_16x16x32_bf16 v[128:131], v[100:103], v[100:103], v[128:131]
    v_mfma_f32_16x16x32_bf16 v[128:131], v[104:107], v[104:107], v[128:131]
    v_mfma_f32_16x16x32_bf16 v[128:131], v[108:111], v[108:111], v[128:131]
    s_nop 7
    v_cndmask_b32 v4, 0, v128, s[60:61]
    v_cndmask_b32 v4, v4, v129, s[62:63]
    v_cndmask_b32 v4, v4, v130, s[64:65]
    v_cndmask_b32 v4, v4, v131, s[66:67]
    v_fma_f32 v4, v4, v28, v30
    v_and_b32 v5, v3, v4
    v_sub_f32 v5, v4, v5
    v_and_b32 v6, v3, v5
    v_perm_b32 v224, v5, v4, s3
    v_sub_f32 v6, v5, v6
    v_lshrrev_b32 v225, 16, v6
    s_nop 1
    v_mfma_f32_16x16x32_bf16 v[228:231], v[232:235], v[224:227], 0
    buffer_load_dwordx4 v[156:159], v243, s[44:47], s6 offen offset:0 sc1
    buffer_load_dwordx4 v[184:187], v243, s[44:47], s6 offen offset:1024 sc1
    buffer_load_dwordx4 v[160:163], v243, s[44:47], s7 offen offset:0 sc1
    buffer_load_dwordx4 v[188:191], v243, s[44:47], s7 offen offset:1024 sc1
    v_mfma_f32_16x16x32_bf16 v[112:115], v[32:35], v[96:99], v[228:231]
    v_mfma_f32_16x16x32_bf16 v[112:115], v[36:39], v[100:103], v[112:115]
    v_mfma_f32_16x16x32_bf16 v[112:115], v[40:43], v[104:107], v[112:115]
    v_mfma_f32_16x16x32_bf16 v[112:115], v[44:47], v[108:111], v[112:115]
    v_mfma_f32_16x16x32_bf16 v[116:119], v[48:51], v[96:99], v[228:231]
    v_mfma_f32_16x16x32_bf16 v[116:119], v[52:55], v[100:103], v[116:119]
    v_mfma_f32_16x16x32_bf16 v[116:119], v[56:59], v[104:107], v[116:119]
    v_mfma_f32_16x16x32_bf16 v[116:119], v[60:63], v[108:111], v[116:119]
    buffer_load_dwordx4 v[164:167], v243, s[44:47], s8 offen offset:0 sc1
    buffer_load_dwordx4 v[192:195], v243, s[44:47], s8 offen offset:1024 sc1
    v_mfma_f32_16x16x32_bf16 v[120:123], v[64:67], v[96:99], v[228:231]
    s_nop 0
    v_exp_f32 v112, v112
    v_mfma_f32_16x16x32_bf16 v[120:123], v[68:71], v[100:103], v[120:123]
    v_exp_f32 v113, v113
    v_mfma_f32_16x16x32_bf16 v[120:123], v[72:75], v[104:107], v[120:123]
    v_exp_f32 v114, v114
    v_mfma_f32_16x16x32_bf16 v[120:123], v[76:79], v[108:111], v[120:123]
    v_exp_f32 v115, v115
    v_mfma_f32_16x16x32_bf16 v[124:127], v[80:83], v[96:99], v[228:231]
    v_add_f32 v112, v27, v112
    v_add_f32 v113, v27, v113
    v_mfma_f32_16x16x32_bf16 v[124:127], v[84:87], v[100:103], v[124:127]
    v_add_f32 v114, v27, v114
    v_add_f32 v115, v27, v115
    v_mfma_f32_16x16x32_bf16 v[124:127], v[88:91], v[104:107], v[124:127]
    v_cvt_pk_bf16_f32 v140, v112, v113
    v_cvt_pk_bf16_f32 v141, v114, v115
    v_mfma_f32_16x16x32_bf16 v[124:127], v[92:95], v[108:111], v[124:127]
    v_exp_f32 v116, v116
    v_exp_f32 v117, v117
    v_exp_f32 v118, v118
    v_exp_f32 v119, v119
    v_add_f32 v116, v27, v116
    v_add_f32 v117, v27, v117
    v_add_f32 v118, v27, v118
    v_add_f32 v119, v27, v119
    v_cvt_pk_bf16_f32 v142, v116, v117
    v_cvt_pk_bf16_f32 v143, v118, v119
    buffer_load_dwordx4 v[168:171], v243, s[44:47], s9 offen offset:0 sc1
    buffer_load_dwordx4 v[196:199], v243, s[44:47], s9 offen offset:1024 sc1
    v_exp_f32 v120, v120
    v_exp_f32 v121, v121
    v_exp_f32 v122, v122
    v_exp_f32 v123, v123
    v_add_f32 v120, v27, v120
    v_add_f32 v121, v27, v121
    v_add_f32 v122, v27, v122
    v_add_f32 v123, v27, v123
    v_cvt_pk_bf16_f32 v144, v120, v121
    v_cvt_pk_bf16_f32 v145, v122, v123
    buffer_load_dwordx4 v[172:175], v243, s[44:47], s10 offen offset:0 sc1
    buffer_load_dwordx4 v[200:203], v243, s[44:47], s10 offen offset:1024 sc1
    v_exp_f32 v124, v124
    v_exp_f32 v125, v125
    v_exp_f32 v126, v126
    v_exp_f32 v127, v127
    v_add_f32 v124, v27, v124
    v_add_f32 v125, v27, v125
    v_add_f32 v126, v27, v126
    v_add_f32 v127, v27, v127
    v_cvt_pk_bf16_f32 v146, v124, v125
    v_cvt_pk_bf16_f32 v147, v126, v127
    s_waitcnt vmcnt(14)
    v_add_f32_dpp v236, v236, v236 quad_perm:[1,0,3,2] row_mask:0xf bank_mask:0xf
    v_add_f32_dpp v237, v237, v237 quad_perm:[1,0,3,2] row_mask:0xf bank_mask:0xf
    v_add_f32_dpp v238, v238, v238 quad_perm:[1,0,3,2] row_mask:0xf bank_mask:0xf
    v_add_f32_dpp v239, v239, v239 quad_perm:[1,0,3,2] row_mask:0xf bank_mask:0xf
    v_add_f32_dpp v236, v236, v236 quad_perm:[2,3,0,1] row_mask:0xf bank_mask:0xf
    v_add_f32_dpp v237, v237, v237 quad_perm:[2,3,0,1] row_mask:0xf bank_mask:0xf
    v_add_f32_dpp v238, v238, v238 quad_perm:[2,3,0,1] row_mask:0xf bank_mask:0xf
    v_add_f32_dpp v239, v239, v239 quad_perm:[2,3,0,1] row_mask:0xf bank_mask:0xf
    v_add_f32_dpp v236, v236, v236 row_half_mirror row_mask:0xf bank_mask:0xf
    v_add_f32_dpp v237, v237, v237 row_half_mirror row_mask:0xf bank_mask:0xf
    v_add_f32_dpp v238, v238, v238 row_half_mirror row_mask:0xf bank_mask:0xf
    v_add_f32_dpp v239, v239, v239 row_half_mirror row_mask:0xf bank_mask:0xf
    v_cvt_pk_bf16_f32 v6, v236, v237
    v_cvt_pk_bf16_f32 v7, v238, v239
    ds_write_b64 v242, v[6:7] offset:8448
    s_waitcnt vmcnt(12)
    v_mfma_f32_16x16x32_bf16 v[208:211], v[248:251], v[148:151], v[208:211]
    v_mfma_f32_16x16x32_bf16 v[216:219], v[248:251], v[176:179], v[216:219]
    s_waitcnt vmcnt(10)
    v_mfma_f32_16x16x32_bf16 v[204:207], v[246:249], v[150:153], v[204:207]
    v_mfma_f32_16x16x32_bf16 v[212:215], v[246:249], v[178:181], v[212:215]
    s_waitcnt vmcnt(8)
    v_mfma_f32_16x16x32_bf16 v[208:211], v[246:249], v[154:157], v[208:211]
    v_mfma_f32_16x16x32_bf16 v[216:219], v[246:249], v[182:185], v[216:219]
    s_waitcnt vmcnt(6)
    v_mfma_f32_16x16x32_bf16 v[204:207], v[246:249], v[158:161], v[204:207]
    v_mfma_f32_16x16x32_bf16 v[212:215], v[246:249], v[186:189], v[212:215]
    s_waitcnt vmcnt(4)
    v_mfma_f32_16x16x32_bf16 v[208:211], v[246:249], v[162:165], v[208:211]
    v_mfma_f32_16x16x32_bf16 v[216:219], v[246:249], v[190:193], v[216:219]
    s_waitcnt vmcnt(2)
    v_mfma_f32_16x16x32_bf16 v[204:207], v[246:249], v[166:169], v[204:207]
    v_mfma_f32_16x16x32_bf16 v[212:215], v[246:249], v[194:197], v[212:215]
    s_waitcnt vmcnt(0)
    v_mfma_f32_16x16x32_bf16 v[208:211], v[246:249], v[170:173], v[208:211]
    v_mfma_f32_16x16x32_bf16 v[204:207], v[244:247], v[172:175], v[204:207]
    v_mfma_f32_16x16x32_bf16 v[216:219], v[246:249], v[198:201], v[216:219]
    v_mfma_f32_16x16x32_bf16 v[212:215], v[244:247], v[200:203], v[212:215]
    s_nop 5
    v_cvt_pk_bf16_f32 v4, v204, v205
    v_cvt_pk_bf16_f32 v5, v206, v207
    ds_write_b64 v240, v[4:5] offset:0
    v_cvt_pk_bf16_f32 v6, v208, v209
    v_cvt_pk_bf16_f32 v7, v210, v211
    ds_write_b64 v241, v[6:7] offset:0
    v_cvt_pk_bf16_f32 v8, v212, v213
    v_cvt_pk_bf16_f32 v9, v214, v215
    ds_write_b64 v240, v[8:9] offset:32
    v_cvt_pk_bf16_f32 v10, v216, v217
    v_cvt_pk_bf16_f32 v11, v218, v219
    ds_write_b64 v241, v[10:11] offset:32
    v_add_u32 v26, 65536, v243
    s_waitcnt lgkmcnt(0)
    s_barrier
    ds_read_b128 v[212:215], v26 offset:8448
    ds_read_b128 v[216:219], v26 offset:18048
    ds_read_b128 v[148:151], v26 offset:0
    ds_read_b128 v[152:155], v26 offset:9600
    ds_read_b128 v[156:159], v26 offset:1056
    ds_read_b128 v[160:163], v26 offset:10656
    ds_read_b128 v[164:167], v26 offset:2112
    ds_read_b128 v[168:171], v26 offset:11712
    ds_read_b128 v[172:175], v26 offset:3168
    ds_read_b128 v[176:179], v26 offset:12768
    ds_read_b128 v[180:183], v26 offset:4224
    ds_read_b128 v[184:187], v26 offset:13824
    ds_read_b128 v[188:191], v26 offset:5280
    ds_read_b128 v[192:195], v26 offset:14880
    ds_read_b128 v[196:199], v26 offset:6336
    ds_read_b128 v[200:203], v26 offset:15936
    ds_read_b128 v[204:207], v26 offset:7392
    ds_read_b128 v[208:211], v26 offset:16992
    s_waitcnt lgkmcnt(14)
    v_mfma_f32_16x16x32_bf16 v[128:131], v[132:135], v[212:215], 0
    v_mfma_f32_16x16x32_bf16 v[128:131], v[136:139], v[216:219], v[128:131]
    v_mfma_f32_16x16x32_bf16 v[96:99], v[132:135], v[148:151], 0
    v_mfma_f32_16x16x32_bf16 v[96:99], v[136:139], v[152:155], v[96:99]
    s_waitcnt lgkmcnt(13)
    v_mfma_f32_16x16x32_bf16 v[100:103], v[132:135], v[156:159], 0
    s_waitcnt lgkmcnt(12)
    v_mfma_f32_16x16x32_bf16 v[100:103], v[136:139], v[160:163], v[100:103]
    s_waitcnt lgkmcnt(11)
    v_mfma_f32_16x16x32_bf16 v[104:107], v[132:135], v[164:167], 0
    s_waitcnt lgkmcnt(10)
    v_mfma_f32_16x16x32_bf16 v[104:107], v[136:139], v[168:171], v[104:107]
    s_waitcnt lgkmcnt(9)
    v_mfma_f32_16x16x32_bf16 v[108:111], v[132:135], v[172:175], 0
    s_waitcnt lgkmcnt(8)
    v_mfma_f32_16x16x32_bf16 v[108:111], v[136:139], v[176:179], v[108:111]
    s_waitcnt lgkmcnt(7)
    v_mfma_f32_16x16x32_bf16 v[112:115], v[132:135], v[180:183], 0
    s_waitcnt lgkmcnt(6)
    v_mfma_f32_16x16x32_bf16 v[112:115], v[136:139], v[184:187], v[112:115]
    s_waitcnt lgkmcnt(5)
    v_mfma_f32_16x16x32_bf16 v[116:119], v[132:135], v[188:191], 0
    s_waitcnt lgkmcnt(4)
    v_mfma_f32_16x16x32_bf16 v[116:119], v[136:139], v[192:195], v[116:119]
    s_waitcnt lgkmcnt(3)
    v_mfma_f32_16x16x32_bf16 v[120:123], v[132:135], v[196:199], 0
    s_waitcnt lgkmcnt(2)
    v_mfma_f32_16x16x32_bf16 v[120:123], v[136:139], v[200:203], v[120:123]
    s_waitcnt lgkmcnt(1)
    v_mfma_f32_16x16x32_bf16 v[124:127], v[132:135], v[204:207], 0
    s_waitcnt lgkmcnt(0)
    v_mfma_f32_16x16x32_bf16 v[124:127], v[136:139], v[208:211], v[124:127]
    v_mfma_f32_16x16x32_bf16 v[64:67], v[140:143], v[212:215], 0
    v_add_f32 v252, v27, v128
    v_add_f32 v253, v27, v129
    v_mfma_f32_16x16x32_bf16 v[64:67], v[144:147], v[216:219], v[64:67]
    v_add_f32 v254, v27, v130
    v_add_f32 v255, v27, v131
    v_mfma_f32_16x16x32_bf16 v[32:35], v[140:143], v[148:151], 0
    v_rcp_f32 v252, v252
    v_rcp_f32 v253, v253
    v_mfma_f32_16x16x32_bf16 v[32:35], v[144:147], v[152:155], v[32:35]
    v_rcp_f32 v254, v254
    v_rcp_f32 v255, v255
    s_mov_b32 s56, 0
    v_mfma_f32_16x16x32_bf16 v[36:39], v[140:143], v[156:159], 0
    v_mul_f32 v96, v252, v96
    v_mul_f32 v100, v252, v100
    v_mul_f32 v104, v252, v104
    v_mul_f32 v108, v252, v108
    v_mfma_f32_16x16x32_bf16 v[36:39], v[144:147], v[160:163], v[36:39]
    v_mul_f32 v112, v252, v112
    v_mul_f32 v116, v252, v116
    v_mul_f32 v120, v252, v120
    v_mul_f32 v124, v252, v124
    v_mfma_f32_16x16x32_bf16 v[40:43], v[140:143], v[164:167], 0
    v_cvt_pk_bf16_f32 v4, v96, v100
    v_cvt_pk_bf16_f32 v5, v104, v108
    v_cvt_pk_bf16_f32 v6, v112, v116
    v_cvt_pk_bf16_f32 v7, v120, v124
    v_mfma_f32_16x16x32_bf16 v[40:43], v[144:147], v[168:171], v[40:43]
    buffer_store_dwordx4 v[4:7], v29, s[36:39], s56 offen offset:0 nt
    v_mul_f32 v97, v253, v97
    v_mul_f32 v101, v253, v101
    v_mul_f32 v105, v253, v105
    v_mfma_f32_16x16x32_bf16 v[44:47], v[140:143], v[172:175], 0
    v_mul_f32 v109, v253, v109
    v_mul_f32 v113, v253, v113
    v_mul_f32 v117, v253, v117
    v_mul_f32 v121, v253, v121
    v_mfma_f32_16x16x32_bf16 v[44:47], v[144:147], v[176:179], v[44:47]
    v_mul_f32 v125, v253, v125
    v_cvt_pk_bf16_f32 v8, v97, v101
    v_cvt_pk_bf16_f32 v9, v105, v109
    v_cvt_pk_bf16_f32 v10, v113, v117
    v_mfma_f32_16x16x32_bf16 v[48:51], v[140:143], v[180:183], 0
    v_cvt_pk_bf16_f32 v11, v121, v125
    buffer_store_dwordx4 v[8:11], v29, s[36:39], s56 offen offset:256 nt
    v_mul_f32 v98, v254, v98
    v_mul_f32 v102, v254, v102
    v_mfma_f32_16x16x32_bf16 v[48:51], v[144:147], v[184:187], v[48:51]
    v_mul_f32 v106, v254, v106
    v_mul_f32 v110, v254, v110
    v_mul_f32 v114, v254, v114
    v_mul_f32 v118, v254, v118
    v_mfma_f32_16x16x32_bf16 v[52:55], v[140:143], v[188:191], 0
    v_mul_f32 v122, v254, v122
    v_mul_f32 v126, v254, v126
    v_cvt_pk_bf16_f32 v4, v98, v102
    v_cvt_pk_bf16_f32 v5, v106, v110
    v_mfma_f32_16x16x32_bf16 v[52:55], v[144:147], v[192:195], v[52:55]
    v_cvt_pk_bf16_f32 v6, v114, v118
    v_cvt_pk_bf16_f32 v7, v122, v126
    buffer_store_dwordx4 v[4:7], v29, s[36:39], s56 offen offset:512 nt
    v_mul_f32 v99, v255, v99
    v_mfma_f32_16x16x32_bf16 v[56:59], v[140:143], v[196:199], 0
    v_mul_f32 v103, v255, v103
    v_mul_f32 v107, v255, v107
    v_mul_f32 v111, v255, v111
    v_mul_f32 v115, v255, v115
    v_mfma_f32_16x16x32_bf16 v[56:59], v[144:147], v[200:203], v[56:59]
    v_mul_f32 v119, v255, v119
    v_mul_f32 v123, v255, v123
    v_mul_f32 v127, v255, v127
    v_cvt_pk_bf16_f32 v8, v99, v103
    v_mfma_f32_16x16x32_bf16 v[60:63], v[140:143], v[204:207], 0
    v_cvt_pk_bf16_f32 v9, v107, v111
    v_cvt_pk_bf16_f32 v10, v115, v119
    v_cvt_pk_bf16_f32 v11, v123, v127
    buffer_store_dwordx4 v[8:11], v29, s[36:39], s56 offen offset:768 nt
    v_mfma_f32_16x16x32_bf16 v[60:63], v[144:147], v[208:211], v[60:63]
    v_add_f32 v252, v27, v64
    v_add_f32 v253, v27, v65
    v_add_f32 v254, v27, v66
    v_add_f32 v255, v27, v67
    v_rcp_f32 v252, v252
    v_rcp_f32 v253, v253
    v_rcp_f32 v254, v254
    v_rcp_f32 v255, v255
    s_mov_b32 s56, 32768
    v_mul_f32 v32, v252, v32
    v_mul_f32 v36, v252, v36
    v_mul_f32 v40, v252, v40
    v_mul_f32 v44, v252, v44
    v_mul_f32 v48, v252, v48
    v_mul_f32 v52, v252, v52
    v_mul_f32 v56, v252, v56
    v_mul_f32 v60, v252, v60
    v_cvt_pk_bf16_f32 v4, v32, v36
    v_cvt_pk_bf16_f32 v5, v40, v44
    v_cvt_pk_bf16_f32 v6, v48, v52
    v_cvt_pk_bf16_f32 v7, v56, v60
    buffer_store_dwordx4 v[4:7], v29, s[36:39], s56 offen offset:0 nt
    v_mul_f32 v33, v253, v33
    v_mul_f32 v37, v253, v37
    v_mul_f32 v41, v253, v41
    v_mul_f32 v45, v253, v45
    v_mul_f32 v49, v253, v49
    v_mul_f32 v53, v253, v53
    v_mul_f32 v57, v253, v57
    v_mul_f32 v61, v253, v61
    v_cvt_pk_bf16_f32 v8, v33, v37
    v_cvt_pk_bf16_f32 v9, v41, v45
    v_cvt_pk_bf16_f32 v10, v49, v53
    v_cvt_pk_bf16_f32 v11, v57, v61
    buffer_store_dwordx4 v[8:11], v29, s[36:39], s56 offen offset:256 nt
    v_mul_f32 v34, v254, v34
    v_mul_f32 v38, v254, v38
    v_mul_f32 v42, v254, v42
    v_mul_f32 v46, v254, v46
    v_mul_f32 v50, v254, v50
    v_mul_f32 v54, v254, v54
    v_mul_f32 v58, v254, v58
    v_mul_f32 v62, v254, v62
    v_cvt_pk_bf16_f32 v4, v34, v38
    v_cvt_pk_bf16_f32 v5, v42, v46
    v_cvt_pk_bf16_f32 v6, v50, v54
    v_cvt_pk_bf16_f32 v7, v58, v62
    buffer_store_dwordx4 v[4:7], v29, s[36:39], s56 offen offset:512 nt
    v_mul_f32 v35, v255, v35
    v_mul_f32 v39, v255, v39
    v_mul_f32 v43, v255, v43
    v_mul_f32 v47, v255, v47
    v_mul_f32 v51, v255, v51
    v_mul_f32 v55, v255, v55
    v_mul_f32 v59, v255, v59
    v_mul_f32 v63, v255, v63
    v_cvt_pk_bf16_f32 v8, v35, v39
    v_cvt_pk_bf16_f32 v9, v43, v47
    v_cvt_pk_bf16_f32 v10, v51, v55
    v_cvt_pk_bf16_f32 v11, v59, v63
    buffer_store_dwordx4 v[8:11], v29, s[36:39], s56 offen offset:768 nt
    s_nop 1
L_end:
    s_endpgm

.section .rodata,"a"
.p2align 6
.amdhsa_kernel standalone__linear_kernel_rfa__prompt_kernel
  .amdhsa_next_free_vgpr 256
  .amdhsa_next_free_sgpr 102
  .amdhsa_accum_offset 256
  .amdhsa_group_segment_fixed_size 0
  .amdhsa_kernarg_size 56
  .amdhsa_user_sgpr_count 2
  .amdhsa_user_sgpr_kernarg_segment_ptr 1
  .amdhsa_system_sgpr_workgroup_id_x 1
.end_amdhsa_kernel
```
